```python
import torch

def _softmax(x, axis=-1):
    return torch.softmax(x, dim=axis)

def _gelu(x):
    return torch.nn.functional.gelu(x, approximate='tanh')

def _silu(x):
    return torch.nn.functional.silu(x)

def _sigmoid(x):
    return torch.sigmoid(x)

def _layernorm(x, axis=-1, eps=1e-05):
    m = x.mean(dim=axis, keepdim=True)
    v = x.var(dim=axis, keepdim=True, unbiased=False)
    return (x - m) / torch.sqrt(v + eps)

def _scatter_add(tgt, idx, src, axis=0):
    return tgt.clone().index_add_(axis, idx, src)

def _segment_sum(src, seg, n):
    out = torch.zeros((n,) + src.shape[1:], dtype=src.dtype)
    return out.index_add_(0, seg, src)

def _pad(x, pw):
    flat = tuple((v for pair in reversed(pw) for v in pair))
    return torch.nn.functional.pad(x, flat)
kernel_name = 'standalone__tree_speculative_verify_tree_attention_over_candidate_token_tree__sampling'

def setup_inputs():

    _w = lambda a: (lambda t: t.to(torch.bfloat16) if t.is_floating_point() else t)(torch.as_tensor(a))
    B, Hq, Hkv, T, C, D = (8, 32, 16, 4, 8192, 128)
    tree_mask = torch.zeros((B, T, T), dtype=float)
    for b in range(B):
        parent = torch.zeros(T, dtype=torch.int64)
        for i in range(1, T):
            parent[i] = int(torch.randint(0, i, (1,)).item())
        for i in range(T):
            j = i
            tree_mask[b, i, j] = 1.0
            while j > 0:
                j = parent[j]
                tree_mask[b, i, j] = 1.0
    return {'q': _w((lambda *s: torch.randn(*s, dtype=torch.bfloat16) * 0.8)(B, Hq, T, D)), 'k_cache': _w((lambda *s: torch.randn(*s, dtype=torch.bfloat16) * 0.8)(B, Hkv, C, D)), 'v_cache': _w((lambda *s: torch.randn(*s, dtype=torch.bfloat16) * 0.05)(B, Hkv, C, D)), 'k_tree': _w((lambda *s: torch.randn(*s, dtype=torch.bfloat16) * 0.8)(B, Hkv, T, D)), 'v_tree': _w((lambda *s: torch.randn(*s, dtype=torch.bfloat16) * 0.05)(B, Hkv, T, D)), 'tree_mask': _w(tree_mask)}

def reference(q, k_cache, v_cache, k_tree, v_tree, tree_mask):
    B, Hq, T, D = q.shape
    Hkv, C = (k_cache.shape[1], k_cache.shape[2])
    rep = Hq // Hkv
    kc = (lambda x, n, axis: torch.repeat_interleave(x, n, dim=axis))(k_cache, rep, axis=1)
    vc = (lambda x, n, axis: torch.repeat_interleave(x, n, dim=axis))(v_cache, rep, axis=1)
    kt = (lambda x, n, axis: torch.repeat_interleave(x, n, dim=axis))(k_tree, rep, axis=1)
    vt = (lambda x, n, axis: torch.repeat_interleave(x, n, dim=axis))(v_tree, rep, axis=1)
    k = torch.concatenate([kc, kt], axis=2)
    v = torch.concatenate([vc, vt], axis=2)
    scale = D ** (-0.5)
    scores = torch.einsum('bhqd,bhkd->bhqk', q, k) * scale
    ctx_mask = torch.ones((B, 1, T, C), dtype=scores.dtype)
    tm = tree_mask[:, None, :, :].clone()
    full_mask = torch.concatenate([ctx_mask, tm], axis=-1)
    scores = scores + (1.0 - full_mask) * -1000000000.0
    p = _softmax(scores, axis=-1)
    return torch.einsum('bhqk,bhkd->bhqd', p, v)
```

```asm
; @launch kernel=attn_part_kernel grid=(256,1,1) block=(256,1,1) lds=65536
; @launch kernel=attn_comb_kernel grid=(256,1,1) block=(256,1,1) lds=0
.amdgcn_target "amdgcn-amd-amdhsa--gfx950"
.text
.globl attn_part_kernel
.p2align 8
.type attn_part_kernel,@function
attn_part_kernel:
s_cmp_ge_u32 s2, 256
s_cbranch_scc1 A_done
s_load_dwordx4 s[4:7], s[0:1], 0
s_load_dwordx2 s[24:25], s[0:1], 16
s_load_dwordx2 s[26:27], s[0:1], 64
v_lshrrev_b32 v1, 6, v0
s_nop 0
v_readfirstlane_b32 s28, v1
v_and_b32 v2, 63, v0
v_and_b32 v3, 15, v2
v_lshrrev_b32 v4, 4, v2
s_lshr_b32 s29, s2, 1
s_and_b32 s30, s2, 1
s_waitcnt lgkmcnt(0)
s_mov_b32 s16, s4
s_mov_b32 s17, s5
s_mov_b32 s18, 0x40000
s_mov_b32 s19, 0x00020000
s_mov_b32 s8, s6
s_mov_b32 s9, s7
s_mov_b32 s10, 0x10000000
s_mov_b32 s11, 0x00020000
s_mov_b32 s12, s24
s_mov_b32 s13, s25
s_mov_b32 s14, 0x10000000
s_mov_b32 s15, 0x00020000
s_mov_b32 s20, s26
s_mov_b32 s21, s27
s_mov_b32 s22, 0x1000000
s_mov_b32 s23, 0x00020000
s_lshl_b32 s31, s29, 21
s_mul_i32 s32, s30, 32768
s_add_u32 s31, s31, s32
s_mul_i32 s32, s28, 8192
s_add_u32 s31, s31, s32
s_lshl_b32 s33, s28, 14
v_and_b32 v5, 7, v2
v_lshlrev_b32 v5, 8, v5
v_lshl_add_u32 v5, v4, 4, v5
s_lshl_b32 s32, s29, 11
buffer_load_dwordx4 v[72:75], v5, s[16:19], s32 offen offset:0
buffer_load_dwordx4 v[76:79], v5, s[16:19], s32 offen offset:64
buffer_load_dwordx4 v[80:83], v5, s[16:19], s32 offen offset:128
buffer_load_dwordx4 v[84:87], v5, s[16:19], s32 offen offset:192
v_lshlrev_b32 v140, 8, v3
v_lshl_add_u32 v140, v4, 4, v140
v_add_u32 v141, 0x1000, v140
v_lshlrev_b32 v5, 1, v4
v_xor_b32 v5, v3, v5
v_lshlrev_b32 v5, 4, v5
v_lshl_add_u32 v142, v4, 8, v5
v_lshrrev_b32 v5, 2, v3
v_and_b32 v6, 3, v3
v_lshl_add_u32 v7, v4, 2, v5
v_lshlrev_b32 v7, 8, v7
v_lshlrev_b32 v1, 3, v6
v_add3_u32 v7, v7, v1, s33
v_xor_b32 v1, 0, v5
v_lshl_add_u32 v143, v1, 5, v7
v_xor_b32 v1, 1, v5
v_lshl_add_u32 v144, v1, 5, v7
v_xor_b32 v1, 2, v5
v_lshl_add_u32 v145, v1, 5, v7
v_xor_b32 v1, 3, v5
v_lshl_add_u32 v146, v1, 5, v7
v_mov_b32 v88, 0
v_mov_b32 v89, 0
v_mov_b32 v90, 0
v_mov_b32 v91, 0
v_mov_b32 v92, 0
v_mov_b32 v93, 0
v_mov_b32 v94, 0
v_mov_b32 v95, 0
v_mov_b32 v96, 0
v_mov_b32 v97, 0
v_mov_b32 v98, 0
v_mov_b32 v99, 0
v_mov_b32 v100, 0
v_mov_b32 v101, 0
v_mov_b32 v102, 0
v_mov_b32 v103, 0
v_mov_b32 v104, 0
v_mov_b32 v105, 0
v_mov_b32 v106, 0
v_mov_b32 v107, 0
v_mov_b32 v108, 0
v_mov_b32 v109, 0
v_mov_b32 v110, 0
v_mov_b32 v111, 0
v_mov_b32 v112, 0
v_mov_b32 v113, 0
v_mov_b32 v114, 0
v_mov_b32 v115, 0
v_mov_b32 v116, 0
v_mov_b32 v117, 0
v_mov_b32 v118, 0
v_mov_b32 v119, 0
v_mov_b32 v148, 0xff61b1e6
v_mov_b32 v149, 0
s_mov_b32 s40, 0x3e0293ee
buffer_load_dwordx4 v[8:11], v140, s[8:11], s31 offen offset:0 nt
buffer_load_dwordx4 v[12:15], v140, s[8:11], s31 offen offset:64 nt
buffer_load_dwordx4 v[16:19], v140, s[8:11], s31 offen offset:128 nt
buffer_load_dwordx4 v[20:23], v140, s[8:11], s31 offen offset:192 nt
buffer_load_dwordx4 v[24:27], v141, s[8:11], s31 offen offset:0 nt
buffer_load_dwordx4 v[28:31], v141, s[8:11], s31 offen offset:64 nt
buffer_load_dwordx4 v[32:35], v141, s[8:11], s31 offen offset:128 nt
buffer_load_dwordx4 v[36:39], v141, s[8:11], s31 offen offset:192 nt
s_add_u32 s34, s33, 0
s_mov_b32 m0, s34
s_add_u32 s35, s31, 0
buffer_load_dwordx4 v142, s[12:15], s35 offen offset:0 nt lds
buffer_load_dwordx4 v142, s[12:15], s35 offen offset:1024 nt lds
buffer_load_dwordx4 v142, s[12:15], s35 offen offset:2048 nt lds
buffer_load_dwordx4 v142, s[12:15], s35 offen offset:3072 nt lds
s_add_u32 s34, s33, 4096
s_mov_b32 m0, s34
s_add_u32 s35, s31, 4096
buffer_load_dwordx4 v142, s[12:15], s35 offen offset:0 nt lds
buffer_load_dwordx4 v142, s[12:15], s35 offen offset:1024 nt lds
buffer_load_dwordx4 v142, s[12:15], s35 offen offset:2048 nt lds
buffer_load_dwordx4 v142, s[12:15], s35 offen offset:3072 nt lds
s_add_u32 s31, s31, 65536
s_mov_b32 s36, 15
A_loop:
buffer_load_dwordx4 v[40:43], v140, s[8:11], s31 offen offset:0 nt
buffer_load_dwordx4 v[44:47], v140, s[8:11], s31 offen offset:64 nt
buffer_load_dwordx4 v[48:51], v140, s[8:11], s31 offen offset:128 nt
buffer_load_dwordx4 v[52:55], v140, s[8:11], s31 offen offset:192 nt
buffer_load_dwordx4 v[56:59], v141, s[8:11], s31 offen offset:0 nt
buffer_load_dwordx4 v[60:63], v141, s[8:11], s31 offen offset:64 nt
buffer_load_dwordx4 v[64:67], v141, s[8:11], s31 offen offset:128 nt
buffer_load_dwordx4 v[68:71], v141, s[8:11], s31 offen offset:192 nt
s_add_u32 s34, s33, 8192
s_mov_b32 m0, s34
s_add_u32 s35, s31, 0
buffer_load_dwordx4 v142, s[12:15], s35 offen offset:0 nt lds
buffer_load_dwordx4 v142, s[12:15], s35 offen offset:1024 nt lds
buffer_load_dwordx4 v142, s[12:15], s35 offen offset:2048 nt lds
buffer_load_dwordx4 v142, s[12:15], s35 offen offset:3072 nt lds
s_add_u32 s34, s33, 12288
s_mov_b32 m0, s34
s_add_u32 s35, s31, 4096
buffer_load_dwordx4 v142, s[12:15], s35 offen offset:0 nt lds
buffer_load_dwordx4 v142, s[12:15], s35 offen offset:1024 nt lds
buffer_load_dwordx4 v142, s[12:15], s35 offen offset:2048 nt lds
buffer_load_dwordx4 v142, s[12:15], s35 offen offset:3072 nt lds
s_add_u32 s31, s31, 65536
s_waitcnt vmcnt(24)
v_mfma_f32_16x16x32_bf16 v[120:123], v[8:11], v[72:75], 0
v_mfma_f32_16x16x32_bf16 v[120:123], v[12:15], v[76:79], v[120:123]
v_mfma_f32_16x16x32_bf16 v[120:123], v[16:19], v[80:83], v[120:123]
v_mfma_f32_16x16x32_bf16 v[120:123], v[20:23], v[84:87], v[120:123]
v_mfma_f32_16x16x32_bf16 v[124:127], v[24:27], v[72:75], 0
v_mfma_f32_16x16x32_bf16 v[124:127], v[28:31], v[76:79], v[124:127]
v_mfma_f32_16x16x32_bf16 v[124:127], v[32:35], v[80:83], v[124:127]
v_mfma_f32_16x16x32_bf16 v[124:127], v[36:39], v[84:87], v[124:127]
s_nop 7
v_max3_f32 v150, v120, v121, v122
v_max3_f32 v151, v123, v124, v125
v_max3_f32 v150, v150, v126, v127
v_max_f32 v150, v150, v151
v_mov_b32 v151, v150
s_nop 1
v_permlane32_swap_b32 v150, v151
v_max_f32 v150, v150, v151
v_mov_b32 v151, v150
s_nop 1
v_permlane16_swap_b32 v150, v151
v_max3_f32 v150, v150, v151, v148
v_sub_f32 v154, v148, v150
v_mul_f32 v154, s40, v154
v_exp_f32 v154, v154
v_cmp_gt_f32 vcc, v150, v148
v_mov_b32 v148, v150
v_mul_f32 v151, s40, v150
v_fma_f32 v120, v120, s40, -v151
v_fma_f32 v121, v121, s40, -v151
v_fma_f32 v122, v122, s40, -v151
v_fma_f32 v123, v123, s40, -v151
v_fma_f32 v124, v124, s40, -v151
v_fma_f32 v125, v125, s40, -v151
v_fma_f32 v126, v126, s40, -v151
v_fma_f32 v127, v127, s40, -v151
v_exp_f32 v120, v120
v_exp_f32 v121, v121
v_exp_f32 v122, v122
v_exp_f32 v123, v123
v_exp_f32 v124, v124
v_exp_f32 v125, v125
v_exp_f32 v126, v126
v_exp_f32 v127, v127
s_cbranch_vccz 1f
v_mul_f32 v88, v88, v154
v_mul_f32 v89, v89, v154
v_mul_f32 v90, v90, v154
v_mul_f32 v91, v91, v154
v_mul_f32 v92, v92, v154
v_mul_f32 v93, v93, v154
v_mul_f32 v94, v94, v154
v_mul_f32 v95, v95, v154
v_mul_f32 v96, v96, v154
v_mul_f32 v97, v97, v154
v_mul_f32 v98, v98, v154
v_mul_f32 v99, v99, v154
v_mul_f32 v100, v100, v154
v_mul_f32 v101, v101, v154
v_mul_f32 v102, v102, v154
v_mul_f32 v103, v103, v154
v_mul_f32 v104, v104, v154
v_mul_f32 v105, v105, v154
v_mul_f32 v106, v106, v154
v_mul_f32 v107, v107, v154
v_mul_f32 v108, v108, v154
v_mul_f32 v109, v109, v154
v_mul_f32 v110, v110, v154
v_mul_f32 v111, v111, v154
v_mul_f32 v112, v112, v154
v_mul_f32 v113, v113, v154
v_mul_f32 v114, v114, v154
v_mul_f32 v115, v115, v154
v_mul_f32 v116, v116, v154
v_mul_f32 v117, v117, v154
v_mul_f32 v118, v118, v154
v_mul_f32 v119, v119, v154
v_mul_f32 v149, v149, v154
1:
v_add_f32 v150, v120, v121
v_add_f32 v151, v122, v123
v_add_f32 v152, v124, v125
v_add_f32 v153, v126, v127
v_cvt_pk_bf16_f32 v128, v120, v121
v_cvt_pk_bf16_f32 v129, v122, v123
v_cvt_pk_bf16_f32 v130, v124, v125
v_cvt_pk_bf16_f32 v131, v126, v127
v_add_f32 v150, v150, v151
v_add_f32 v152, v152, v153
v_add_f32 v149, v149, v150
v_add_f32 v149, v149, v152
s_waitcnt vmcnt(16)
ds_read_b64_tr_b16 v[132:133], v143 offset:0
ds_read_b64_tr_b16 v[134:135], v143 offset:4096
ds_read_b64_tr_b16 v[136:137], v144 offset:0
ds_read_b64_tr_b16 v[138:139], v144 offset:4096
s_waitcnt lgkmcnt(2)
v_mfma_f32_16x16x32_bf16 v[88:91], v[132:135], v[128:131], v[88:91]
ds_read_b64_tr_b16 v[132:133], v145 offset:0
ds_read_b64_tr_b16 v[134:135], v145 offset:4096
s_waitcnt lgkmcnt(2)
v_mfma_f32_16x16x32_bf16 v[92:95], v[136:139], v[128:131], v[92:95]
ds_read_b64_tr_b16 v[136:137], v146 offset:0
ds_read_b64_tr_b16 v[138:139], v146 offset:4096
s_waitcnt lgkmcnt(2)
v_mfma_f32_16x16x32_bf16 v[96:99], v[132:135], v[128:131], v[96:99]
ds_read_b64_tr_b16 v[132:133], v143 offset:128
ds_read_b64_tr_b16 v[134:135], v143 offset:4224
s_waitcnt lgkmcnt(2)
v_mfma_f32_16x16x32_bf16 v[100:103], v[136:139], v[128:131], v[100:103]
ds_read_b64_tr_b16 v[136:137], v144 offset:128
ds_read_b64_tr_b16 v[138:139], v144 offset:4224
s_waitcnt lgkmcnt(2)
v_mfma_f32_16x16x32_bf16 v[104:107], v[132:135], v[128:131], v[104:107]
ds_read_b64_tr_b16 v[132:133], v145 offset:128
ds_read_b64_tr_b16 v[134:135], v145 offset:4224
s_waitcnt lgkmcnt(2)
v_mfma_f32_16x16x32_bf16 v[108:111], v[136:139], v[128:131], v[108:111]
ds_read_b64_tr_b16 v[136:137], v146 offset:128
ds_read_b64_tr_b16 v[138:139], v146 offset:4224
s_waitcnt lgkmcnt(2)
v_mfma_f32_16x16x32_bf16 v[112:115], v[132:135], v[128:131], v[112:115]
s_waitcnt lgkmcnt(0)
v_mfma_f32_16x16x32_bf16 v[116:119], v[136:139], v[128:131], v[116:119]
buffer_load_dwordx4 v[8:11], v140, s[8:11], s31 offen offset:0 nt
buffer_load_dwordx4 v[12:15], v140, s[8:11], s31 offen offset:64 nt
buffer_load_dwordx4 v[16:19], v140, s[8:11], s31 offen offset:128 nt
buffer_load_dwordx4 v[20:23], v140, s[8:11], s31 offen offset:192 nt
buffer_load_dwordx4 v[24:27], v141, s[8:11], s31 offen offset:0 nt
buffer_load_dwordx4 v[28:31], v141, s[8:11], s31 offen offset:64 nt
buffer_load_dwordx4 v[32:35], v141, s[8:11], s31 offen offset:128 nt
buffer_load_dwordx4 v[36:39], v141, s[8:11], s31 offen offset:192 nt
s_add_u32 s34, s33, 0
s_mov_b32 m0, s34
s_add_u32 s35, s31, 0
buffer_load_dwordx4 v142, s[12:15], s35 offen offset:0 nt lds
buffer_load_dwordx4 v142, s[12:15], s35 offen offset:1024 nt lds
buffer_load_dwordx4 v142, s[12:15], s35 offen offset:2048 nt lds
buffer_load_dwordx4 v142, s[12:15], s35 offen offset:3072 nt lds
s_add_u32 s34, s33, 4096
s_mov_b32 m0, s34
s_add_u32 s35, s31, 4096
buffer_load_dwordx4 v142, s[12:15], s35 offen offset:0 nt lds
buffer_load_dwordx4 v142, s[12:15], s35 offen offset:1024 nt lds
buffer_load_dwordx4 v142, s[12:15], s35 offen offset:2048 nt lds
buffer_load_dwordx4 v142, s[12:15], s35 offen offset:3072 nt lds
s_add_u32 s31, s31, 65536
s_waitcnt vmcnt(24)
v_mfma_f32_16x16x32_bf16 v[120:123], v[40:43], v[72:75], 0
v_mfma_f32_16x16x32_bf16 v[120:123], v[44:47], v[76:79], v[120:123]
v_mfma_f32_16x16x32_bf16 v[120:123], v[48:51], v[80:83], v[120:123]
v_mfma_f32_16x16x32_bf16 v[120:123], v[52:55], v[84:87], v[120:123]
v_mfma_f32_16x16x32_bf16 v[124:127], v[56:59], v[72:75], 0
v_mfma_f32_16x16x32_bf16 v[124:127], v[60:63], v[76:79], v[124:127]
v_mfma_f32_16x16x32_bf16 v[124:127], v[64:67], v[80:83], v[124:127]
v_mfma_f32_16x16x32_bf16 v[124:127], v[68:71], v[84:87], v[124:127]
s_nop 7
v_max3_f32 v150, v120, v121, v122
v_max3_f32 v151, v123, v124, v125
v_max3_f32 v150, v150, v126, v127
v_max_f32 v150, v150, v151
v_mov_b32 v151, v150
s_nop 1
v_permlane32_swap_b32 v150, v151
v_max_f32 v150, v150, v151
v_mov_b32 v151, v150
s_nop 1
v_permlane16_swap_b32 v150, v151
v_max3_f32 v150, v150, v151, v148
v_sub_f32 v154, v148, v150
v_mul_f32 v154, s40, v154
v_exp_f32 v154, v154
v_cmp_gt_f32 vcc, v150, v148
v_mov_b32 v148, v150
v_mul_f32 v151, s40, v150
v_fma_f32 v120, v120, s40, -v151
v_fma_f32 v121, v121, s40, -v151
v_fma_f32 v122, v122, s40, -v151
v_fma_f32 v123, v123, s40, -v151
v_fma_f32 v124, v124, s40, -v151
v_fma_f32 v125, v125, s40, -v151
v_fma_f32 v126, v126, s40, -v151
v_fma_f32 v127, v127, s40, -v151
v_exp_f32 v120, v120
v_exp_f32 v121, v121
v_exp_f32 v122, v122
v_exp_f32 v123, v123
v_exp_f32 v124, v124
v_exp_f32 v125, v125
v_exp_f32 v126, v126
v_exp_f32 v127, v127
s_cbranch_vccz 1f
v_mul_f32 v88, v88, v154
v_mul_f32 v89, v89, v154
v_mul_f32 v90, v90, v154
v_mul_f32 v91, v91, v154
v_mul_f32 v92, v92, v154
v_mul_f32 v93, v93, v154
v_mul_f32 v94, v94, v154
v_mul_f32 v95, v95, v154
v_mul_f32 v96, v96, v154
v_mul_f32 v97, v97, v154
v_mul_f32 v98, v98, v154
v_mul_f32 v99, v99, v154
v_mul_f32 v100, v100, v154
v_mul_f32 v101, v101, v154
v_mul_f32 v102, v102, v154
v_mul_f32 v103, v103, v154
v_mul_f32 v104, v104, v154
v_mul_f32 v105, v105, v154
v_mul_f32 v106, v106, v154
v_mul_f32 v107, v107, v154
v_mul_f32 v108, v108, v154
v_mul_f32 v109, v109, v154
v_mul_f32 v110, v110, v154
v_mul_f32 v111, v111, v154
v_mul_f32 v112, v112, v154
v_mul_f32 v113, v113, v154
v_mul_f32 v114, v114, v154
v_mul_f32 v115, v115, v154
v_mul_f32 v116, v116, v154
v_mul_f32 v117, v117, v154
v_mul_f32 v118, v118, v154
v_mul_f32 v119, v119, v154
v_mul_f32 v149, v149, v154
1:
v_add_f32 v150, v120, v121
v_add_f32 v151, v122, v123
v_add_f32 v152, v124, v125
v_add_f32 v153, v126, v127
v_cvt_pk_bf16_f32 v128, v120, v121
v_cvt_pk_bf16_f32 v129, v122, v123
v_cvt_pk_bf16_f32 v130, v124, v125
v_cvt_pk_bf16_f32 v131, v126, v127
v_add_f32 v150, v150, v151
v_add_f32 v152, v152, v153
v_add_f32 v149, v149, v150
v_add_f32 v149, v149, v152
s_waitcnt vmcnt(16)
ds_read_b64_tr_b16 v[132:133], v143 offset:8192
ds_read_b64_tr_b16 v[134:135], v143 offset:12288
ds_read_b64_tr_b16 v[136:137], v144 offset:8192
ds_read_b64_tr_b16 v[138:139], v144 offset:12288
s_waitcnt lgkmcnt(2)
v_mfma_f32_16x16x32_bf16 v[88:91], v[132:135], v[128:131], v[88:91]
ds_read_b64_tr_b16 v[132:133], v145 offset:8192
ds_read_b64_tr_b16 v[134:135], v145 offset:12288
s_waitcnt lgkmcnt(2)
v_mfma_f32_16x16x32_bf16 v[92:95], v[136:139], v[128:131], v[92:95]
ds_read_b64_tr_b16 v[136:137], v146 offset:8192
ds_read_b64_tr_b16 v[138:139], v146 offset:12288
s_waitcnt lgkmcnt(2)
v_mfma_f32_16x16x32_bf16 v[96:99], v[132:135], v[128:131], v[96:99]
ds_read_b64_tr_b16 v[132:133], v143 offset:8320
ds_read_b64_tr_b16 v[134:135], v143 offset:12416
s_waitcnt lgkmcnt(2)
v_mfma_f32_16x16x32_bf16 v[100:103], v[136:139], v[128:131], v[100:103]
ds_read_b64_tr_b16 v[136:137], v144 offset:8320
ds_read_b64_tr_b16 v[138:139], v144 offset:12416
s_waitcnt lgkmcnt(2)
v_mfma_f32_16x16x32_bf16 v[104:107], v[132:135], v[128:131], v[104:107]
ds_read_b64_tr_b16 v[132:133], v145 offset:8320
ds_read_b64_tr_b16 v[134:135], v145 offset:12416
s_waitcnt lgkmcnt(2)
v_mfma_f32_16x16x32_bf16 v[108:111], v[136:139], v[128:131], v[108:111]
ds_read_b64_tr_b16 v[136:137], v146 offset:8320
ds_read_b64_tr_b16 v[138:139], v146 offset:12416
s_waitcnt lgkmcnt(2)
v_mfma_f32_16x16x32_bf16 v[112:115], v[132:135], v[128:131], v[112:115]
s_waitcnt lgkmcnt(0)
v_mfma_f32_16x16x32_bf16 v[116:119], v[136:139], v[128:131], v[116:119]
s_sub_u32 s36, s36, 1
s_cmp_lg_u32 s36, 0
s_cbranch_scc1 A_loop
buffer_load_dwordx4 v[40:43], v140, s[8:11], s31 offen offset:0 nt
buffer_load_dwordx4 v[44:47], v140, s[8:11], s31 offen offset:64 nt
buffer_load_dwordx4 v[48:51], v140, s[8:11], s31 offen offset:128 nt
buffer_load_dwordx4 v[52:55], v140, s[8:11], s31 offen offset:192 nt
buffer_load_dwordx4 v[56:59], v141, s[8:11], s31 offen offset:0 nt
buffer_load_dwordx4 v[60:63], v141, s[8:11], s31 offen offset:64 nt
buffer_load_dwordx4 v[64:67], v141, s[8:11], s31 offen offset:128 nt
buffer_load_dwordx4 v[68:71], v141, s[8:11], s31 offen offset:192 nt
s_add_u32 s34, s33, 8192
s_mov_b32 m0, s34
s_add_u32 s35, s31, 0
buffer_load_dwordx4 v142, s[12:15], s35 offen offset:0 nt lds
buffer_load_dwordx4 v142, s[12:15], s35 offen offset:1024 nt lds
buffer_load_dwordx4 v142, s[12:15], s35 offen offset:2048 nt lds
buffer_load_dwordx4 v142, s[12:15], s35 offen offset:3072 nt lds
s_add_u32 s34, s33, 12288
s_mov_b32 m0, s34
s_add_u32 s35, s31, 4096
buffer_load_dwordx4 v142, s[12:15], s35 offen offset:0 nt lds
buffer_load_dwordx4 v142, s[12:15], s35 offen offset:1024 nt lds
buffer_load_dwordx4 v142, s[12:15], s35 offen offset:2048 nt lds
buffer_load_dwordx4 v142, s[12:15], s35 offen offset:3072 nt lds
s_add_u32 s31, s31, 65536
s_waitcnt vmcnt(24)
v_mfma_f32_16x16x32_bf16 v[120:123], v[8:11], v[72:75], 0
v_mfma_f32_16x16x32_bf16 v[120:123], v[12:15], v[76:79], v[120:123]
v_mfma_f32_16x16x32_bf16 v[120:123], v[16:19], v[80:83], v[120:123]
v_mfma_f32_16x16x32_bf16 v[120:123], v[20:23], v[84:87], v[120:123]
v_mfma_f32_16x16x32_bf16 v[124:127], v[24:27], v[72:75], 0
v_mfma_f32_16x16x32_bf16 v[124:127], v[28:31], v[76:79], v[124:127]
v_mfma_f32_16x16x32_bf16 v[124:127], v[32:35], v[80:83], v[124:127]
v_mfma_f32_16x16x32_bf16 v[124:127], v[36:39], v[84:87], v[124:127]
s_nop 7
v_max3_f32 v150, v120, v121, v122
v_max3_f32 v151, v123, v124, v125
v_max3_f32 v150, v150, v126, v127
v_max_f32 v150, v150, v151
v_mov_b32 v151, v150
s_nop 1
v_permlane32_swap_b32 v150, v151
v_max_f32 v150, v150, v151
v_mov_b32 v151, v150
s_nop 1
v_permlane16_swap_b32 v150, v151
v_max3_f32 v150, v150, v151, v148
v_sub_f32 v154, v148, v150
v_mul_f32 v154, s40, v154
v_exp_f32 v154, v154
v_cmp_gt_f32 vcc, v150, v148
v_mov_b32 v148, v150
v_mul_f32 v151, s40, v150
v_fma_f32 v120, v120, s40, -v151
v_fma_f32 v121, v121, s40, -v151
v_fma_f32 v122, v122, s40, -v151
v_fma_f32 v123, v123, s40, -v151
v_fma_f32 v124, v124, s40, -v151
v_fma_f32 v125, v125, s40, -v151
v_fma_f32 v126, v126, s40, -v151
v_fma_f32 v127, v127, s40, -v151
v_exp_f32 v120, v120
v_exp_f32 v121, v121
v_exp_f32 v122, v122
v_exp_f32 v123, v123
v_exp_f32 v124, v124
v_exp_f32 v125, v125
v_exp_f32 v126, v126
v_exp_f32 v127, v127
s_cbranch_vccz 1f
v_mul_f32 v88, v88, v154
v_mul_f32 v89, v89, v154
v_mul_f32 v90, v90, v154
v_mul_f32 v91, v91, v154
v_mul_f32 v92, v92, v154
v_mul_f32 v93, v93, v154
v_mul_f32 v94, v94, v154
v_mul_f32 v95, v95, v154
v_mul_f32 v96, v96, v154
v_mul_f32 v97, v97, v154
v_mul_f32 v98, v98, v154
v_mul_f32 v99, v99, v154
v_mul_f32 v100, v100, v154
v_mul_f32 v101, v101, v154
v_mul_f32 v102, v102, v154
v_mul_f32 v103, v103, v154
v_mul_f32 v104, v104, v154
v_mul_f32 v105, v105, v154
v_mul_f32 v106, v106, v154
v_mul_f32 v107, v107, v154
v_mul_f32 v108, v108, v154
v_mul_f32 v109, v109, v154
v_mul_f32 v110, v110, v154
v_mul_f32 v111, v111, v154
v_mul_f32 v112, v112, v154
v_mul_f32 v113, v113, v154
v_mul_f32 v114, v114, v154
v_mul_f32 v115, v115, v154
v_mul_f32 v116, v116, v154
v_mul_f32 v117, v117, v154
v_mul_f32 v118, v118, v154
v_mul_f32 v119, v119, v154
v_mul_f32 v149, v149, v154
1:
v_add_f32 v150, v120, v121
v_add_f32 v151, v122, v123
v_add_f32 v152, v124, v125
v_add_f32 v153, v126, v127
v_cvt_pk_bf16_f32 v128, v120, v121
v_cvt_pk_bf16_f32 v129, v122, v123
v_cvt_pk_bf16_f32 v130, v124, v125
v_cvt_pk_bf16_f32 v131, v126, v127
v_add_f32 v150, v150, v151
v_add_f32 v152, v152, v153
v_add_f32 v149, v149, v150
v_add_f32 v149, v149, v152
s_waitcnt vmcnt(16)
ds_read_b64_tr_b16 v[132:133], v143 offset:0
ds_read_b64_tr_b16 v[134:135], v143 offset:4096
ds_read_b64_tr_b16 v[136:137], v144 offset:0
ds_read_b64_tr_b16 v[138:139], v144 offset:4096
s_waitcnt lgkmcnt(2)
v_mfma_f32_16x16x32_bf16 v[88:91], v[132:135], v[128:131], v[88:91]
ds_read_b64_tr_b16 v[132:133], v145 offset:0
ds_read_b64_tr_b16 v[134:135], v145 offset:4096
s_waitcnt lgkmcnt(2)
v_mfma_f32_16x16x32_bf16 v[92:95], v[136:139], v[128:131], v[92:95]
ds_read_b64_tr_b16 v[136:137], v146 offset:0
ds_read_b64_tr_b16 v[138:139], v146 offset:4096
s_waitcnt lgkmcnt(2)
v_mfma_f32_16x16x32_bf16 v[96:99], v[132:135], v[128:131], v[96:99]
ds_read_b64_tr_b16 v[132:133], v143 offset:128
ds_read_b64_tr_b16 v[134:135], v143 offset:4224
s_waitcnt lgkmcnt(2)
v_mfma_f32_16x16x32_bf16 v[100:103], v[136:139], v[128:131], v[100:103]
ds_read_b64_tr_b16 v[136:137], v144 offset:128
ds_read_b64_tr_b16 v[138:139], v144 offset:4224
s_waitcnt lgkmcnt(2)
v_mfma_f32_16x16x32_bf16 v[104:107], v[132:135], v[128:131], v[104:107]
ds_read_b64_tr_b16 v[132:133], v145 offset:128
ds_read_b64_tr_b16 v[134:135], v145 offset:4224
s_waitcnt lgkmcnt(2)
v_mfma_f32_16x16x32_bf16 v[108:111], v[136:139], v[128:131], v[108:111]
ds_read_b64_tr_b16 v[136:137], v146 offset:128
ds_read_b64_tr_b16 v[138:139], v146 offset:4224
s_waitcnt lgkmcnt(2)
v_mfma_f32_16x16x32_bf16 v[112:115], v[132:135], v[128:131], v[112:115]
s_waitcnt lgkmcnt(0)
v_mfma_f32_16x16x32_bf16 v[116:119], v[136:139], v[128:131], v[116:119]
s_waitcnt vmcnt(8)
v_mfma_f32_16x16x32_bf16 v[120:123], v[40:43], v[72:75], 0
v_mfma_f32_16x16x32_bf16 v[120:123], v[44:47], v[76:79], v[120:123]
v_mfma_f32_16x16x32_bf16 v[120:123], v[48:51], v[80:83], v[120:123]
v_mfma_f32_16x16x32_bf16 v[120:123], v[52:55], v[84:87], v[120:123]
v_mfma_f32_16x16x32_bf16 v[124:127], v[56:59], v[72:75], 0
v_mfma_f32_16x16x32_bf16 v[124:127], v[60:63], v[76:79], v[124:127]
v_mfma_f32_16x16x32_bf16 v[124:127], v[64:67], v[80:83], v[124:127]
v_mfma_f32_16x16x32_bf16 v[124:127], v[68:71], v[84:87], v[124:127]
s_nop 7
v_max3_f32 v150, v120, v121, v122
v_max3_f32 v151, v123, v124, v125
v_max3_f32 v150, v150, v126, v127
v_max_f32 v150, v150, v151
v_mov_b32 v151, v150
s_nop 1
v_permlane32_swap_b32 v150, v151
v_max_f32 v150, v150, v151
v_mov_b32 v151, v150
s_nop 1
v_permlane16_swap_b32 v150, v151
v_max3_f32 v150, v150, v151, v148
v_sub_f32 v154, v148, v150
v_mul_f32 v154, s40, v154
v_exp_f32 v154, v154
v_cmp_gt_f32 vcc, v150, v148
v_mov_b32 v148, v150
v_mul_f32 v151, s40, v150
v_fma_f32 v120, v120, s40, -v151
v_fma_f32 v121, v121, s40, -v151
v_fma_f32 v122, v122, s40, -v151
v_fma_f32 v123, v123, s40, -v151
v_fma_f32 v124, v124, s40, -v151
v_fma_f32 v125, v125, s40, -v151
v_fma_f32 v126, v126, s40, -v151
v_fma_f32 v127, v127, s40, -v151
v_exp_f32 v120, v120
v_exp_f32 v121, v121
v_exp_f32 v122, v122
v_exp_f32 v123, v123
v_exp_f32 v124, v124
v_exp_f32 v125, v125
v_exp_f32 v126, v126
v_exp_f32 v127, v127
s_cbranch_vccz 1f
v_mul_f32 v88, v88, v154
v_mul_f32 v89, v89, v154
v_mul_f32 v90, v90, v154
v_mul_f32 v91, v91, v154
v_mul_f32 v92, v92, v154
v_mul_f32 v93, v93, v154
v_mul_f32 v94, v94, v154
v_mul_f32 v95, v95, v154
v_mul_f32 v96, v96, v154
v_mul_f32 v97, v97, v154
v_mul_f32 v98, v98, v154
v_mul_f32 v99, v99, v154
v_mul_f32 v100, v100, v154
v_mul_f32 v101, v101, v154
v_mul_f32 v102, v102, v154
v_mul_f32 v103, v103, v154
v_mul_f32 v104, v104, v154
v_mul_f32 v105, v105, v154
v_mul_f32 v106, v106, v154
v_mul_f32 v107, v107, v154
v_mul_f32 v108, v108, v154
v_mul_f32 v109, v109, v154
v_mul_f32 v110, v110, v154
v_mul_f32 v111, v111, v154
v_mul_f32 v112, v112, v154
v_mul_f32 v113, v113, v154
v_mul_f32 v114, v114, v154
v_mul_f32 v115, v115, v154
v_mul_f32 v116, v116, v154
v_mul_f32 v117, v117, v154
v_mul_f32 v118, v118, v154
v_mul_f32 v119, v119, v154
v_mul_f32 v149, v149, v154
1:
v_add_f32 v150, v120, v121
v_add_f32 v151, v122, v123
v_add_f32 v152, v124, v125
v_add_f32 v153, v126, v127
v_cvt_pk_bf16_f32 v128, v120, v121
v_cvt_pk_bf16_f32 v129, v122, v123
v_cvt_pk_bf16_f32 v130, v124, v125
v_cvt_pk_bf16_f32 v131, v126, v127
v_add_f32 v150, v150, v151
v_add_f32 v152, v152, v153
v_add_f32 v149, v149, v150
v_add_f32 v149, v149, v152
s_waitcnt vmcnt(0)
ds_read_b64_tr_b16 v[132:133], v143 offset:8192
ds_read_b64_tr_b16 v[134:135], v143 offset:12288
ds_read_b64_tr_b16 v[136:137], v144 offset:8192
ds_read_b64_tr_b16 v[138:139], v144 offset:12288
s_waitcnt lgkmcnt(2)
v_mfma_f32_16x16x32_bf16 v[88:91], v[132:135], v[128:131], v[88:91]
ds_read_b64_tr_b16 v[132:133], v145 offset:8192
ds_read_b64_tr_b16 v[134:135], v145 offset:12288
s_waitcnt lgkmcnt(2)
v_mfma_f32_16x16x32_bf16 v[92:95], v[136:139], v[128:131], v[92:95]
ds_read_b64_tr_b16 v[136:137], v146 offset:8192
ds_read_b64_tr_b16 v[138:139], v146 offset:12288
s_waitcnt lgkmcnt(2)
v_mfma_f32_16x16x32_bf16 v[96:99], v[132:135], v[128:131], v[96:99]
ds_read_b64_tr_b16 v[132:133], v143 offset:8320
ds_read_b64_tr_b16 v[134:135], v143 offset:12416
s_waitcnt lgkmcnt(2)
v_mfma_f32_16x16x32_bf16 v[100:103], v[136:139], v[128:131], v[100:103]
ds_read_b64_tr_b16 v[136:137], v144 offset:8320
ds_read_b64_tr_b16 v[138:139], v144 offset:12416
s_waitcnt lgkmcnt(2)
v_mfma_f32_16x16x32_bf16 v[104:107], v[132:135], v[128:131], v[104:107]
ds_read_b64_tr_b16 v[132:133], v145 offset:8320
ds_read_b64_tr_b16 v[134:135], v145 offset:12416
s_waitcnt lgkmcnt(2)
v_mfma_f32_16x16x32_bf16 v[108:111], v[136:139], v[128:131], v[108:111]
ds_read_b64_tr_b16 v[136:137], v146 offset:8320
ds_read_b64_tr_b16 v[138:139], v146 offset:12416
s_waitcnt lgkmcnt(2)
v_mfma_f32_16x16x32_bf16 v[112:115], v[132:135], v[128:131], v[112:115]
s_waitcnt lgkmcnt(0)
v_mfma_f32_16x16x32_bf16 v[116:119], v[136:139], v[128:131], v[116:119]
v_mov_b32 v151, v149
s_nop 1
v_permlane32_swap_b32 v149, v151
v_add_f32 v149, v149, v151
v_mov_b32 v151, v149
s_nop 1
v_permlane16_swap_b32 v149, v151
v_add_f32 v149, v149, v151
s_nop 7
v_lshlrev_b32 v5, 9, v3
v_lshl_add_u32 v5, v4, 4, v5
v_add_u32 v5, s33, v5
ds_write_b128 v5, v[88:91] offset:0
ds_write_b128 v5, v[92:95] offset:64
ds_write_b128 v5, v[96:99] offset:128
ds_write_b128 v5, v[100:103] offset:192
ds_write_b128 v5, v[104:107] offset:256
ds_write_b128 v5, v[108:111] offset:320
ds_write_b128 v5, v[112:115] offset:384
ds_write_b128 v5, v[116:119] offset:448
v_lshl_add_u32 v6, v3, 3, s33
ds_write_b64 v6, v[148:149] offset:8192
s_waitcnt lgkmcnt(0)
s_barrier
v_lshrrev_b32 v5, 5, v0
v_and_b32 v6, 31, v0
v_lshlrev_b32 v7, 3, v5
v_lshlrev_b32 v1, 9, v5
v_lshl_add_u32 v1, v6, 4, v1
ds_read_b64 v[8:9], v7 offset:8192
ds_read_b128 v[16:19], v1 offset:0
ds_read_b64 v[10:11], v7 offset:24576
ds_read_b128 v[20:23], v1 offset:16384
ds_read_b64 v[12:13], v7 offset:40960
ds_read_b128 v[24:27], v1 offset:32768
ds_read_b64 v[14:15], v7 offset:57344
ds_read_b128 v[28:31], v1 offset:49152
s_waitcnt lgkmcnt(0)
v_max3_f32 v32, v8, v10, v12
v_max_f32 v32, v32, v14
v_sub_f32 v33, v8, v32
v_mul_f32 v33, s40, v33
v_exp_f32 v33, v33
v_sub_f32 v34, v10, v32
v_mul_f32 v34, s40, v34
v_exp_f32 v34, v34
v_sub_f32 v35, v12, v32
v_mul_f32 v35, s40, v35
v_exp_f32 v35, v35
v_sub_f32 v36, v14, v32
v_mul_f32 v36, s40, v36
v_exp_f32 v36, v36
s_nop 0
v_mul_f32 v37, v9, v33
v_mul_f32 v40, v16, v33
v_mul_f32 v41, v17, v33
v_mul_f32 v42, v18, v33
v_mul_f32 v43, v19, v33
v_fmac_f32 v37, v11, v34
v_fmac_f32 v40, v20, v34
v_fmac_f32 v41, v21, v34
v_fmac_f32 v42, v22, v34
v_fmac_f32 v43, v23, v34
v_fmac_f32 v37, v13, v35
v_fmac_f32 v40, v24, v35
v_fmac_f32 v41, v25, v35
v_fmac_f32 v42, v26, v35
v_fmac_f32 v43, v27, v35
v_fmac_f32 v37, v15, v36
v_fmac_f32 v40, v28, v36
v_fmac_f32 v41, v29, v36
v_fmac_f32 v42, v30, v36
v_fmac_f32 v43, v31, v36
s_lshl_b32 s32, s2, 12
buffer_store_dwordx4 v[40:43], v1, s[20:23], s32 offen
v_mov_b32 v36, v32
v_cmp_eq_u32 vcc, 0, v6
s_and_saveexec_b64 s[38:39], vcc
s_lshl_b32 s32, s2, 6
s_add_u32 s32, s32, 0x800000
buffer_store_dwordx2 v[36:37], v7, s[20:23], s32 offen
A_done:
s_endpgm
.globl attn_comb_kernel
.p2align 8
.type attn_comb_kernel,@function
attn_comb_kernel:
s_cmp_ge_u32 s2, 256
s_cbranch_scc1 B_done
s_load_dwordx2 s[4:5], s[0:1], 0
s_load_dwordx4 s[24:27], s[0:1], 24
s_load_dwordx4 s[28:31], s[0:1], 40
s_load_dwordx2 s[6:7], s[0:1], 64
v_lshrrev_b32 v1, 6, v0
s_nop 0
v_readfirstlane_b32 s3, v1
v_and_b32 v2, 63, v0
s_lshl_b32 s32, s2, 2
s_add_u32 s32, s32, s3
s_waitcnt lgkmcnt(0)
s_mov_b32 s8, s4
s_mov_b32 s9, s5
s_mov_b32 s10, 0x40000
s_mov_b32 s11, 0x00020000
s_mov_b32 s12, s24
s_mov_b32 s13, s25
s_mov_b32 s14, 0x20000
s_mov_b32 s15, 0x00020000
s_mov_b32 s16, s26
s_mov_b32 s17, s27
s_mov_b32 s18, 0x20000
s_mov_b32 s19, 0x00020000
s_mov_b32 s20, s6
s_mov_b32 s21, s7
s_mov_b32 s22, 0x1000000
s_mov_b32 s23, 0x00020000
s_mov_b32 s44, s28
s_mov_b32 s45, s29
s_mov_b32 s46, 256
s_mov_b32 s47, 0x00020000
s_mov_b32 s48, s30
s_mov_b32 s49, s31
s_mov_b32 s50, 0x40000
s_mov_b32 s51, 0x00020000
s_lshr_b32 s33, s32, 3
s_and_b32 s34, s32, 7
s_and_b32 s35, s32, 3
s_lshr_b32 s36, s32, 7
v_lshlrev_b32 v3, 2, v2
s_lshl_b32 s37, s32, 8
buffer_load_dword v4, v3, s[8:11], s37 offen
s_lshl_b32 s37, s33, 10
buffer_load_dword v5, v3, s[12:15], s37 offen offset:0
buffer_load_dword v9, v3, s[16:19], s37 offen offset:0
buffer_load_dword v6, v3, s[12:15], s37 offen offset:256
buffer_load_dword v10, v3, s[16:19], s37 offen offset:256
buffer_load_dword v7, v3, s[12:15], s37 offen offset:512
buffer_load_dword v11, v3, s[16:19], s37 offen offset:512
buffer_load_dword v8, v3, s[12:15], s37 offen offset:768
buffer_load_dword v12, v3, s[16:19], s37 offen offset:768
s_lshl_b32 s37, s36, 5
s_lshl_b32 s38, s35, 3
s_add_u32 s37, s37, s38
v_mov_b32 v13, 0
buffer_load_dwordx2 v[14:15], v13, s[44:47], s37 offen
v_lshlrev_b32 v16, 3, v2
s_lshl_b32 s38, s34, 9
s_mul_i32 s37, s33, 8192
s_add_u32 s37, s37, 0
s_add_u32 s37, s37, s38
buffer_load_dwordx2 v[20:21], v16, s[20:23], s37 offen
s_mul_i32 s37, s33, 128
s_add_u32 s37, s37, 8388608
s_lshl_b32 s39, s34, 3
s_add_u32 s37, s37, s39
buffer_load_dwordx2 v[40:41], v13, s[20:23], s37 offen
s_mul_i32 s37, s33, 8192
s_add_u32 s37, s37, 4096
s_add_u32 s37, s37, s38
buffer_load_dwordx2 v[22:23], v16, s[20:23], s37 offen
s_mul_i32 s37, s33, 128
s_add_u32 s37, s37, 8388672
s_lshl_b32 s39, s34, 3
s_add_u32 s37, s37, s39
buffer_load_dwordx2 v[42:43], v13, s[20:23], s37 offen
s_waitcnt vmcnt(4)
v_lshlrev_b32 v60, 16, v4
v_and_b32 v61, 0xffff0000, v4
v_lshlrev_b32 v62, 16, v5
v_and_b32 v63, 0xffff0000, v5
v_mul_f32 v64, v60, v62
v_fmac_f32 v64, v61, v63
v_lshlrev_b32 v62, 16, v6
v_and_b32 v63, 0xffff0000, v6
v_mul_f32 v65, v60, v62
v_fmac_f32 v65, v61, v63
v_lshlrev_b32 v62, 16, v7
v_and_b32 v63, 0xffff0000, v7
v_mul_f32 v66, v60, v62
v_fmac_f32 v66, v61, v63
v_lshlrev_b32 v62, 16, v8
v_and_b32 v63, 0xffff0000, v8
v_mul_f32 v67, v60, v62
v_fmac_f32 v67, v61, v63
s_nop 1
v_add_f32_dpp v64, v64, v64 quad_perm:[1,0,3,2] row_mask:0xf bank_mask:0xf
v_add_f32_dpp v65, v65, v65 quad_perm:[1,0,3,2] row_mask:0xf bank_mask:0xf
v_add_f32_dpp v66, v66, v66 quad_perm:[1,0,3,2] row_mask:0xf bank_mask:0xf
v_add_f32_dpp v67, v67, v67 quad_perm:[1,0,3,2] row_mask:0xf bank_mask:0xf
s_nop 1
v_add_f32_dpp v64, v64, v64 quad_perm:[2,3,0,1] row_mask:0xf bank_mask:0xf
v_add_f32_dpp v65, v65, v65 quad_perm:[2,3,0,1] row_mask:0xf bank_mask:0xf
v_add_f32_dpp v66, v66, v66 quad_perm:[2,3,0,1] row_mask:0xf bank_mask:0xf
v_add_f32_dpp v67, v67, v67 quad_perm:[2,3,0,1] row_mask:0xf bank_mask:0xf
s_nop 1
v_add_f32_dpp v64, v64, v64 row_half_mirror row_mask:0xf bank_mask:0xf
v_add_f32_dpp v65, v65, v65 row_half_mirror row_mask:0xf bank_mask:0xf
v_add_f32_dpp v66, v66, v66 row_half_mirror row_mask:0xf bank_mask:0xf
v_add_f32_dpp v67, v67, v67 row_half_mirror row_mask:0xf bank_mask:0xf
s_nop 1
v_add_f32_dpp v64, v64, v64 row_mirror row_mask:0xf bank_mask:0xf
v_add_f32_dpp v65, v65, v65 row_mirror row_mask:0xf bank_mask:0xf
v_add_f32_dpp v66, v66, v66 row_mirror row_mask:0xf bank_mask:0xf
v_add_f32_dpp v67, v67, v67 row_mirror row_mask:0xf bank_mask:0xf
v_mov_b32 v68, v64
v_mov_b32 v69, v65
v_mov_b32 v70, v66
v_mov_b32 v71, v67
s_nop 1
v_permlane32_swap_b32 v64, v68
v_permlane32_swap_b32 v65, v69
v_permlane32_swap_b32 v66, v70
v_permlane32_swap_b32 v67, v71
v_add_f32 v64, v64, v68
v_add_f32 v65, v65, v69
v_add_f32 v66, v66, v70
v_add_f32 v67, v67, v71
v_mov_b32 v68, v64
v_mov_b32 v69, v65
v_mov_b32 v70, v66
v_mov_b32 v71, v67
s_nop 1
v_permlane16_swap_b32 v64, v68
v_permlane16_swap_b32 v65, v69
v_permlane16_swap_b32 v66, v70
v_permlane16_swap_b32 v67, v71
v_add_f32 v64, v64, v68
v_add_f32 v65, v65, v69
v_add_f32 v66, v66, v70
v_add_f32 v67, v67, v71
s_mov_b32 s40, 0x3e0293ee
s_mov_b32 s41, 0xce6e6b28
s_mov_b32 s42, 0x3fb8aa3b
v_lshlrev_b32 v68, 16, v14
v_and_b32 v69, 0xffff0000, v14
v_lshlrev_b32 v70, 16, v15
v_and_b32 v71, 0xffff0000, v15
v_sub_f32 v68, 1.0, v68
v_mul_f32 v68, s41, v68
v_mul_f32 v68, s42, v68
v_fmac_f32 v68, s40, v64
v_sub_f32 v69, 1.0, v69
v_mul_f32 v69, s41, v69
v_mul_f32 v69, s42, v69
v_fmac_f32 v69, s40, v65
v_sub_f32 v70, 1.0, v70
v_mul_f32 v70, s41, v70
v_mul_f32 v70, s42, v70
v_fmac_f32 v70, s40, v66
v_sub_f32 v71, 1.0, v71
v_mul_f32 v71, s41, v71
v_mul_f32 v71, s42, v71
v_fmac_f32 v71, s40, v67
s_waitcnt vmcnt(0)
v_mul_f32 v40, s40, v40
v_mul_f32 v42, s40, v42
v_max3_f32 v72, v68, v69, v70
v_max_f32 v72, v72, v71
v_max_f32 v72, v72, v40
v_max_f32 v72, v72, v42
v_mov_b32 v73, 0
v_mov_b32 v74, 0
v_mov_b32 v75, 0
v_sub_f32 v40, v40, v72
v_exp_f32 v40, v40
s_nop 0
v_fmac_f32 v73, v40, v41
v_fmac_f32 v74, v40, v20
v_fmac_f32 v75, v40, v21
v_sub_f32 v42, v42, v72
v_exp_f32 v42, v42
s_nop 0
v_fmac_f32 v73, v42, v43
v_fmac_f32 v74, v42, v22
v_fmac_f32 v75, v42, v23
v_sub_f32 v68, v68, v72
v_exp_f32 v68, v68
s_nop 0
v_lshlrev_b32 v62, 16, v9
v_and_b32 v63, 0xffff0000, v9
v_add_f32 v73, v73, v68
v_fmac_f32 v74, v68, v62
v_fmac_f32 v75, v68, v63
v_sub_f32 v69, v69, v72
v_exp_f32 v69, v69
s_nop 0
v_lshlrev_b32 v62, 16, v10
v_and_b32 v63, 0xffff0000, v10
v_add_f32 v73, v73, v69
v_fmac_f32 v74, v69, v62
v_fmac_f32 v75, v69, v63
v_sub_f32 v70, v70, v72
v_exp_f32 v70, v70
s_nop 0
v_lshlrev_b32 v62, 16, v11
v_and_b32 v63, 0xffff0000, v11
v_add_f32 v73, v73, v70
v_fmac_f32 v74, v70, v62
v_fmac_f32 v75, v70, v63
v_sub_f32 v71, v71, v72
v_exp_f32 v71, v71
s_nop 0
v_lshlrev_b32 v62, 16, v12
v_and_b32 v63, 0xffff0000, v12
v_add_f32 v73, v73, v71
v_fmac_f32 v74, v71, v62
v_fmac_f32 v75, v71, v63
v_rcp_f32 v73, v73
s_nop 0
v_mul_f32 v74, v74, v73
v_mul_f32 v75, v75, v73
v_cvt_pk_bf16_f32 v74, v74, v75
s_lshl_b32 s37, s32, 8
buffer_store_dword v74, v3, s[48:51], s37 offen
B_done:
s_endpgm
.section .rodata,"a"
.p2align 6
.amdhsa_kernel attn_part_kernel
  .amdhsa_next_free_vgpr 155
  .amdhsa_next_free_sgpr 64
  .amdhsa_accum_offset 156
  .amdhsa_group_segment_fixed_size 0
  .amdhsa_kernarg_size 72
  .amdhsa_user_sgpr_count 2
  .amdhsa_user_sgpr_kernarg_segment_ptr 1
  .amdhsa_system_sgpr_workgroup_id_x 1
.end_amdhsa_kernel
.p2align 6
.amdhsa_kernel attn_comb_kernel
  .amdhsa_next_free_vgpr 80
  .amdhsa_next_free_sgpr 64
  .amdhsa_accum_offset 80
  .amdhsa_group_segment_fixed_size 0
  .amdhsa_kernarg_size 72
  .amdhsa_user_sgpr_count 2
  .amdhsa_user_sgpr_kernarg_segment_ptr 1
  .amdhsa_system_sgpr_workgroup_id_x 1
.end_amdhsa_kernel
```
